```python
import torch

def _softmax(x, axis=-1):
    return torch.softmax(x, dim=axis)
def _gelu(x):
    return torch.nn.functional.gelu(x, approximate="tanh")
def _silu(x):
    return torch.nn.functional.silu(x)
def _sigmoid(x):
    return torch.sigmoid(x)
def _layernorm(x, axis=-1, eps=1e-5):
    m = x.mean(dim=axis, keepdim=True)
    v = x.var(dim=axis, keepdim=True, unbiased=False)
    return (x - m) / torch.sqrt(v + eps)
def _scatter_add(tgt, idx, src, axis=0):
    return tgt.clone().index_add_(axis, idx, src)
def _segment_sum(src, seg, n):
    out = torch.zeros((n,) + src.shape[1:], dtype=src.dtype)
    return out.index_add_(0, seg, src)
def _pad(x, pw):
    flat = tuple(v for pair in reversed(pw) for v in pair)
    return torch.nn.functional.pad(x, flat)

kernel_name = 'standalone__self_sup_conv_stem_hubert__speech'

def setup_inputs():

    _w = (lambda a: (lambda t: t.to(torch.bfloat16) if t.is_floating_point() else t)(torch.as_tensor(a)))
    B, T, D, K = 2, 4000, 256, 31
    scale = (1.0 / (K * D)) ** 0.5
    return {
        "x": _w((lambda *s: torch.randn(*s, dtype=torch.bfloat16) * 0.05)(B, T, D)),
        "w": _w((lambda *s: torch.randn(*s, dtype=torch.bfloat16) * 0.05)(K, D, D) * scale),
        "b": _w((lambda *s: torch.randn(*s, dtype=torch.bfloat16) * 0.05)(D) * 0.1),
        "gamma": _w(torch.ones((D,), dtype=float)),
        "beta": _w(torch.zeros((D,), dtype=float)),
    }

def reference(x, w, b, gamma, beta):
    B, T, D = x.shape
    K = w.shape[0]
    s = 2
    L = (T - K) // s + 1
    y = torch.einsum('blc,cd->bld', x[:, 0 : s * L : s, :], w[0])
    for i in range(1, K):
        y = y + torch.einsum('blc,cd->bld', x[:, i : i + s * L : s, :], w[i])
    y = y + b[None, None, :]
    mu = y.mean(1, keepdims=True)
    var = ((y - mu) ** 2).mean(1, keepdims=True)
    yn = (y - mu) / torch.sqrt(var + 1e-5)
    yn = yn * gamma[None, None, :] + beta[None, None, :]
    return _gelu(yn)
```

```asm
; @launch kernel=conv_kernel grid=(256,1,1) block=(576,1,1) lds=147456
; @launch kernel=norm_kernel grid=(256,1,1) block=(512,1,1) lds=2048
.amdgcn_target "amdgcn-amd-amdhsa--gfx950"
.text
.globl conv_kernel
.p2align 8
.type conv_kernel,@function
conv_kernel:
    s_cmp_ge_u32 s2, 256
    s_cbranch_scc1 L1_end
    s_load_dwordx4 s[4:7], s[0:1], 0
    s_load_dwordx2 s[8:9], s[0:1], 16
    s_load_dwordx2 s[10:11], s[0:1], 40
    s_load_dwordx2 s[12:13], s[0:1], 56
    v_and_b32 v1, 63, v0
    v_lshrrev_b32 v16, 6, v0
    v_and_b32 v2, 31, v0
    v_lshrrev_b32 v3, 5, v1
    v_readfirstlane_b32 s36, v16
    s_and_b32 s58, s2, 7
    s_lshr_b32 s59, s2, 3
    s_lshr_b32 s37, s58, 2
    s_and_b32 s58, s58, 3
    s_lshl_b32 s58, s58, 1
    s_and_b32 s60, s59, 1
    s_or_b32 s39, s58, s60
    s_lshr_b32 s38, s59, 1
    s_lshl_b32 s48, s38, 7
    s_lshl_b32 s49, s39, 5
    s_and_b32 s45, s36, 3
    v_lshrrev_b32 v16, 3, v1
    v_and_b32 v17, 7, v1
    s_lshl_b32 s58, s36, 3
    v_add_u32 v16, s58, v16
    v_mul_u32_u24 v18, 1821, v16
    v_lshrrev_b32 v18, 16, v18
    v_mul_u32_u24 v19, 36, v18
    v_sub_u32 v19, v16, v19
    v_lshlrev_b32 v20, 3, v19
    v_add_u32 v20, v20, v18
    v_lshlrev_b32 v20, 9, v20
    v_lshrrev_b32 v19, 1, v19
    v_and_b32 v19, 7, v19
    v_xor_b32 v19, v17, v19
    v_lshlrev_b32 v19, 4, v19
    v_or_b32 v10, v20, v19
    v_add_u32 v16, 64, v16
    v_mul_u32_u24 v18, 1821, v16
    v_lshrrev_b32 v18, 16, v18
    v_mul_u32_u24 v19, 36, v18
    v_sub_u32 v19, v16, v19
    v_lshlrev_b32 v20, 3, v19
    v_add_u32 v20, v20, v18
    v_lshlrev_b32 v20, 9, v20
    v_lshrrev_b32 v19, 1, v19
    v_and_b32 v19, 7, v19
    v_xor_b32 v19, v17, v19
    v_lshlrev_b32 v19, 4, v19
    v_or_b32 v11, v20, v19
    v_add_u32 v16, 64, v16
    v_mul_u32_u24 v18, 1821, v16
    v_lshrrev_b32 v18, 16, v18
    v_mul_u32_u24 v19, 36, v18
    v_sub_u32 v19, v16, v19
    v_lshlrev_b32 v20, 3, v19
    v_add_u32 v20, v20, v18
    v_lshlrev_b32 v20, 9, v20
    v_lshrrev_b32 v19, 1, v19
    v_and_b32 v19, 7, v19
    v_xor_b32 v19, v17, v19
    v_lshlrev_b32 v19, 4, v19
    v_or_b32 v12, v20, v19
    v_add_u32 v16, 64, v16
    v_mul_u32_u24 v18, 1821, v16
    v_lshrrev_b32 v18, 16, v18
    v_mul_u32_u24 v19, 36, v18
    v_sub_u32 v19, v16, v19
    v_lshlrev_b32 v20, 3, v19
    v_add_u32 v20, v20, v18
    v_lshlrev_b32 v20, 9, v20
    v_lshrrev_b32 v19, 1, v19
    v_and_b32 v19, 7, v19
    v_xor_b32 v19, v17, v19
    v_lshlrev_b32 v19, 4, v19
    v_or_b32 v13, v20, v19
    v_add_u32 v16, 64, v16
    v_mul_u32_u24 v18, 1821, v16
    v_lshrrev_b32 v18, 16, v18
    v_mul_u32_u24 v19, 36, v18
    v_sub_u32 v19, v16, v19
    v_lshlrev_b32 v20, 3, v19
    v_add_u32 v20, v20, v18
    v_lshlrev_b32 v20, 9, v20
    v_lshrrev_b32 v19, 1, v19
    v_and_b32 v19, 7, v19
    v_xor_b32 v19, v17, v19
    v_lshlrev_b32 v19, 4, v19
    v_or_b32 v14, v20, v19
    s_mul_i32 s58, s37, 4000
    s_lshl_b32 s59, s38, 8
    s_add_u32 s58, s58, s59
    s_lshl_b32 s44, s58, 9
    s_lshl_b32 s50, s36, 10
    s_mov_b32 s43, s50
    s_waitcnt lgkmcnt(0)
    s_mov_b32 s16, s4
    s_mov_b32 s17, s5
    s_mov_b32 s18, 4096000
    s_mov_b32 s19, 0x00020000
    s_mov_b32 s20, s6
    s_mov_b32 s21, s7
    s_mov_b32 s22, 4063232
    s_mov_b32 s23, 0x00020000
    s_mov_b32 s32, s8
    s_mov_b32 s33, s9
    s_mov_b32 s34, 512
    s_mov_b32 s35, 0x00020000
    s_mov_b32 s24, s10
    s_mov_b32 s25, s11
    s_mov_b32 s26, 2032640
    s_mov_b32 s27, 0x00020000
    s_mov_b32 s28, s12
    s_mov_b32 s29, s13
    s_mov_b32 s30, 65536
    s_mov_b32 s31, 0x00020000
    s_cmp_eq_u32 s36, 8
    s_cbranch_scc1 L1_pf
    s_lshl_b32 s52, s45, 10
    s_add_u32 s52, s52, 139264
    s_add_u32 s51, s43, 32768
    s_cmp_ge_u32 s36, 4
    s_cselect_b32 s51, s52, s51
    s_add_u32 m0, s43, 0
    s_nop 0
    buffer_load_dwordx4 v10, s[16:19], s44 offen lds
    s_add_u32 m0, s43, 8192
    s_nop 0
    buffer_load_dwordx4 v11, s[16:19], s44 offen lds
    s_add_u32 m0, s43, 16384
    s_nop 0
    buffer_load_dwordx4 v12, s[16:19], s44 offen lds
    s_add_u32 m0, s43, 24576
    s_nop 0
    buffer_load_dwordx4 v13, s[16:19], s44 offen lds
    s_mov_b32 m0, s51
    s_nop 0
    buffer_load_dwordx4 v14, s[16:19], s44 offen lds
    s_add_u32 s44, s44, 128
    v_lshrrev_b32 v16, 2, v1
    v_lshlrev_b32 v16, 9, v16
    v_and_b32 v17, 3, v1
    v_lshlrev_b32 v17, 4, v17
    v_or_b32 v9, v16, v17
    s_lshl_b32 s58, s45, 3
    s_lshr_b32 s59, s36, 2
    s_add_u32 s58, s58, s59
    s_lshl_b32 s40, s58, 17
    s_lshl_b32 s58, s49, 1
    s_add_u32 s40, s40, s58
    s_lshl_b32 s41, s36, 13
    s_add_u32 s41, s41, 73728
    s_add_u32 m0, s41, 0
    s_add_u32 s47, s40, 0
    buffer_load_dwordx4 v9, s[20:23], s47 offen lds
    s_add_u32 m0, s41, 1024
    s_add_u32 s47, s40, 262144
    buffer_load_dwordx4 v9, s[20:23], s47 offen lds
    s_add_u32 m0, s41, 2048
    s_add_u32 s47, s40, 524288
    buffer_load_dwordx4 v9, s[20:23], s47 offen lds
    s_add_u32 m0, s41, 3072
    s_add_u32 s47, s40, 786432
    buffer_load_dwordx4 v9, s[20:23], s47 offen lds
    s_add_u32 m0, s41, 4096
    s_add_u32 s47, s40, 8192
    buffer_load_dwordx4 v9, s[20:23], s47 offen lds
    s_add_u32 m0, s41, 5120
    s_add_u32 s47, s40, 270336
    buffer_load_dwordx4 v9, s[20:23], s47 offen lds
    s_add_u32 m0, s41, 6144
    s_add_u32 s47, s40, 532480
    buffer_load_dwordx4 v9, s[20:23], s47 offen lds
    s_add_u32 m0, s41, 7168
    s_add_u32 s47, s40, 794624
    buffer_load_dwordx4 v9, s[20:23], s47 offen lds
    v_add_u32 v16, s49, v2
    v_lshlrev_b32 v16, 1, v16
    buffer_load_ushort v15, v16, s[32:35], 0 offen
    s_lshr_b32 s59, s36, 2
    s_mul_i32 s59, s59, 4608
    v_add_u32 v16, s45, v2
    v_lshrrev_b32 v17, 1, v16
    v_and_b32 v17, 7, v17
    v_xor_b32 v17, v3, v17
    v_lshlrev_b32 v17, 4, v17
    v_lshlrev_b32 v16, 7, v16
    v_or_b32 v16, v16, v17
    v_add_u32 v4, s59, v16
    v_add_u32 v16, s45, v2
    v_add_u32 v16, 1, v16
    v_lshrrev_b32 v17, 1, v16
    v_and_b32 v17, 7, v17
    v_xor_b32 v17, v3, v17
    v_lshlrev_b32 v17, 4, v17
    v_lshlrev_b32 v16, 7, v16
    v_or_b32 v16, v16, v17
    v_add_u32 v5, s59, v16
    v_and_b32 v16, 15, v1
    v_lshrrev_b32 v17, 2, v16
    v_and_b32 v18, 3, v16
    v_lshlrev_b32 v19, 3, v3
    v_add_u32 v19, v19, v17
    v_lshlrev_b32 v19, 6, v19
    v_lshrrev_b32 v17, 4, v1
    v_and_b32 v17, 1, v17
    v_lshlrev_b32 v17, 5, v17
    v_add_u32 v19, v19, v17
    v_lshlrev_b32 v18, 3, v18
    v_add_u32 v19, v19, v18
    v_add_u32 v8, s41, v19
    v_mov_b32 v32, 0
    v_mov_b32 v33, 0
    v_mov_b32 v34, 0
    v_mov_b32 v35, 0
    v_mov_b32 v36, 0
    v_mov_b32 v37, 0
    v_mov_b32 v38, 0
    v_mov_b32 v39, 0
    v_mov_b32 v40, 0
    v_mov_b32 v41, 0
    v_mov_b32 v42, 0
    v_mov_b32 v43, 0
    v_mov_b32 v44, 0
    v_mov_b32 v45, 0
    v_mov_b32 v46, 0
    v_mov_b32 v47, 0
    v_mov_b32 v48, 0
    v_mov_b32 v49, 0
    v_mov_b32 v50, 0
    v_mov_b32 v51, 0
    v_mov_b32 v52, 0
    v_mov_b32 v53, 0
    v_mov_b32 v54, 0
    v_mov_b32 v55, 0
    v_mov_b32 v56, 0
    v_mov_b32 v57, 0
    v_mov_b32 v58, 0
    v_mov_b32 v59, 0
    v_mov_b32 v60, 0
    v_mov_b32 v61, 0
    v_mov_b32 v62, 0
    v_mov_b32 v63, 0
    v_mov_b32 v64, 0
    v_mov_b32 v65, 0
    v_mov_b32 v66, 0
    v_mov_b32 v67, 0
    v_mov_b32 v68, 0
    v_mov_b32 v69, 0
    v_mov_b32 v70, 0
    v_mov_b32 v71, 0
    v_mov_b32 v72, 0
    v_mov_b32 v73, 0
    v_mov_b32 v74, 0
    v_mov_b32 v75, 0
    v_mov_b32 v76, 0
    v_mov_b32 v77, 0
    v_mov_b32 v78, 0
    v_mov_b32 v79, 0
    v_mov_b32 v80, 0
    v_mov_b32 v81, 0
    v_mov_b32 v82, 0
    v_mov_b32 v83, 0
    v_mov_b32 v84, 0
    v_mov_b32 v85, 0
    v_mov_b32 v86, 0
    v_mov_b32 v87, 0
    v_mov_b32 v88, 0
    v_mov_b32 v89, 0
    v_mov_b32 v90, 0
    v_mov_b32 v91, 0
    v_mov_b32 v92, 0
    v_mov_b32 v93, 0
    v_mov_b32 v94, 0
    v_mov_b32 v95, 0
    s_mov_b32 s42, 0
    s_add_u32 s43, s43, 36864
    s_add_u32 s51, s43, 32768
    s_cmp_ge_u32 s36, 4
    s_cselect_b32 s51, s52, s51
    s_mov_b32 s46, 0
    s_cmp_eq_u32 s36, 7
    s_cselect_b64 vcc, -1, 0
    s_waitcnt vmcnt(9)
    s_barrier
    v_add_u32 v6, s42, v4
    v_add_u32 v7, s42, v5
    ds_read_b128 v[96:99], v6 offset:0
    ds_read_b128 v[100:103], v6 offset:9216
    ds_read_b128 v[104:107], v6 offset:18432
    ds_read_b128 v[108:111], v6 offset:27648
    ds_read_b128 v[112:115], v7 offset:0
    ds_read_b128 v[116:119], v7 offset:9216
    ds_read_b128 v[120:123], v7 offset:18432
    s_waitcnt vmcnt(6)
    ds_read_b64_tr_b16 v[152:153], v8 offset:0
    ds_read_b64_tr_b16 v[154:155], v8 offset:256
    ds_read_b64_tr_b16 v[156:157], v8 offset:1024
    ds_read_b64_tr_b16 v[158:159], v8 offset:1280
    ds_read_b64_tr_b16 v[160:161], v8 offset:2048
    ds_read_b64_tr_b16 v[162:163], v8 offset:2304
    s_waitcnt lgkmcnt(0)
    s_add_u32 m0, s41, 0
    s_add_u32 s47, s40, 16384
    buffer_load_dwordx4 v9, s[20:23], s47 offen lds
    s_add_u32 m0, s41, 1024
    s_add_u32 s47, s40, 278528
    buffer_load_dwordx4 v9, s[20:23], s47 offen lds
L1_loop:
    s_waitcnt lgkmcnt(0)
    v_mfma_f32_32x32x16_bf16 v[32:47], v[96:99], v[152:155], v[32:47]
    s_waitcnt vmcnt(6)
    ds_read_b64_tr_b16 v[164:165], v8 offset:3072
    ds_read_b64_tr_b16 v[166:167], v8 offset:3328
    v_mfma_f32_32x32x16_bf16 v[48:63], v[100:103], v[152:155], v[48:63]
    v_xor_b32 v6, 32, v6
    v_xor_b32 v7, 32, v7
    ds_read_b128 v[124:127], v6 offset:0
    ds_read_b128 v[128:131], v6 offset:9216
    s_add_u32 m0, s41, 2048
    s_add_u32 s47, s40, 540672
    buffer_load_dwordx4 v9, s[20:23], s47 offen lds
    v_mfma_f32_32x32x16_bf16 v[64:79], v[104:107], v[152:155], v[64:79]
    s_add_u32 m0, s43, 0
    s_nop 0
    buffer_load_dwordx4 v10, s[16:19], s44 offen lds
    v_mfma_f32_32x32x16_bf16 v[80:95], v[108:111], v[152:155], v[80:95]
    s_waitcnt lgkmcnt(0)
    v_mfma_f32_32x32x16_bf16 v[32:47], v[100:103], v[156:159], v[32:47]
    s_waitcnt vmcnt(7)
    ds_read_b64_tr_b16 v[152:153], v8 offset:4096
    ds_read_b64_tr_b16 v[154:155], v8 offset:4352
    v_mfma_f32_32x32x16_bf16 v[48:63], v[104:107], v[156:159], v[48:63]
    ds_read_b128 v[132:135], v6 offset:18432
    ds_read_b128 v[136:139], v6 offset:27648
    s_add_u32 m0, s41, 3072
    s_add_u32 s47, s40, 802816
    buffer_load_dwordx4 v9, s[20:23], s47 offen lds
    v_mfma_f32_32x32x16_bf16 v[64:79], v[108:111], v[156:159], v[64:79]
    s_add_u32 m0, s43, 8192
    s_nop 0
    buffer_load_dwordx4 v11, s[16:19], s44 offen lds
    v_mfma_f32_32x32x16_bf16 v[80:95], v[112:115], v[156:159], v[80:95]
    s_waitcnt lgkmcnt(0)
    v_mfma_f32_32x32x16_bf16 v[32:47], v[104:107], v[160:163], v[32:47]
    s_waitcnt vmcnt(8)
    ds_read_b64_tr_b16 v[156:157], v8 offset:5120
    ds_read_b64_tr_b16 v[158:159], v8 offset:5376
    v_mfma_f32_32x32x16_bf16 v[48:63], v[108:111], v[160:163], v[48:63]
    ds_read_b128 v[140:143], v7 offset:0
    ds_read_b128 v[144:147], v7 offset:9216
    s_add_u32 m0, s41, 4096
    s_add_u32 s47, s40, 24576
    buffer_load_dwordx4 v9, s[20:23], s47 offen lds
    v_mfma_f32_32x32x16_bf16 v[64:79], v[112:115], v[160:163], v[64:79]
    s_add_u32 m0, s43, 16384
    s_nop 0
    buffer_load_dwordx4 v12, s[16:19], s44 offen lds
    v_mfma_f32_32x32x16_bf16 v[80:95], v[116:119], v[160:163], v[80:95]
    s_waitcnt lgkmcnt(0)
    s_cbranch_vccnz L1_skip0_3_0
    v_mfma_f32_32x32x16_bf16 v[32:47], v[108:111], v[164:167], v[32:47]
L1_skip0_3_0:
    s_waitcnt vmcnt(9)
    ds_read_b64_tr_b16 v[160:161], v8 offset:6144
    ds_read_b64_tr_b16 v[162:163], v8 offset:6400
    s_cbranch_vccnz L1_skip0_3_1
    v_mfma_f32_32x32x16_bf16 v[48:63], v[112:115], v[164:167], v[48:63]
L1_skip0_3_1:
    ds_read_b128 v[148:151], v7 offset:18432
    s_add_u32 m0, s41, 5120
    s_add_u32 s47, s40, 286720
    buffer_load_dwordx4 v9, s[20:23], s47 offen lds
    s_cbranch_vccnz L1_skip0_3_2
    v_mfma_f32_32x32x16_bf16 v[64:79], v[116:119], v[164:167], v[64:79]
L1_skip0_3_2:
    s_add_u32 m0, s43, 24576
    s_nop 0
    buffer_load_dwordx4 v13, s[16:19], s44 offen lds
    s_cbranch_vccnz L1_skip0_3_3
    v_mfma_f32_32x32x16_bf16 v[80:95], v[120:123], v[164:167], v[80:95]
L1_skip0_3_3:
    s_waitcnt lgkmcnt(0)
    v_mfma_f32_32x32x16_bf16 v[32:47], v[124:127], v[152:155], v[32:47]
    s_waitcnt vmcnt(10)
    ds_read_b64_tr_b16 v[164:165], v8 offset:7168
    ds_read_b64_tr_b16 v[166:167], v8 offset:7424
    v_mfma_f32_32x32x16_bf16 v[48:63], v[128:131], v[152:155], v[48:63]
    v_xor_b32 v6, 96, v6
    v_xor_b32 v7, 96, v7
    ds_read_b128 v[96:99], v6 offset:0
    ds_read_b128 v[100:103], v6 offset:9216
    s_add_u32 m0, s41, 6144
    s_add_u32 s47, s40, 548864
    buffer_load_dwordx4 v9, s[20:23], s47 offen lds
    v_mfma_f32_32x32x16_bf16 v[64:79], v[132:135], v[152:155], v[64:79]
    s_mov_b32 m0, s51
    s_nop 0
    buffer_load_dwordx4 v14, s[16:19], s44 offen lds
    v_mfma_f32_32x32x16_bf16 v[80:95], v[136:139], v[152:155], v[80:95]
    s_waitcnt lgkmcnt(0)
    v_mfma_f32_32x32x16_bf16 v[32:47], v[128:131], v[156:159], v[32:47]
    s_waitcnt vmcnt(11)
    ds_read_b64_tr_b16 v[152:153], v8 offset:0
    ds_read_b64_tr_b16 v[154:155], v8 offset:256
    v_mfma_f32_32x32x16_bf16 v[48:63], v[132:135], v[156:159], v[48:63]
    ds_read_b128 v[104:107], v6 offset:18432
    ds_read_b128 v[108:111], v6 offset:27648
    s_add_u32 m0, s41, 7168
    s_add_u32 s47, s40, 811008
    buffer_load_dwordx4 v9, s[20:23], s47 offen lds
    v_mfma_f32_32x32x16_bf16 v[64:79], v[136:139], v[156:159], v[64:79]
    v_mfma_f32_32x32x16_bf16 v[80:95], v[140:143], v[156:159], v[80:95]
    s_waitcnt lgkmcnt(0)
    v_mfma_f32_32x32x16_bf16 v[32:47], v[132:135], v[160:163], v[32:47]
    s_waitcnt vmcnt(11)
    ds_read_b64_tr_b16 v[156:157], v8 offset:1024
    ds_read_b64_tr_b16 v[158:159], v8 offset:1280
    v_mfma_f32_32x32x16_bf16 v[48:63], v[136:139], v[160:163], v[48:63]
    ds_read_b128 v[112:115], v7 offset:0
    ds_read_b128 v[116:119], v7 offset:9216
    s_add_u32 m0, s41, 0
    s_add_u32 s47, s40, 32768
    buffer_load_dwordx4 v9, s[20:23], s47 offen lds
    v_mfma_f32_32x32x16_bf16 v[64:79], v[140:143], v[160:163], v[64:79]
    v_mfma_f32_32x32x16_bf16 v[80:95], v[144:147], v[160:163], v[80:95]
    s_waitcnt lgkmcnt(0)
    s_cbranch_vccnz L1_skip0_7_0
    v_mfma_f32_32x32x16_bf16 v[32:47], v[136:139], v[164:167], v[32:47]
L1_skip0_7_0:
    s_waitcnt vmcnt(11)
    ds_read_b64_tr_b16 v[160:161], v8 offset:2048
    ds_read_b64_tr_b16 v[162:163], v8 offset:2304
    s_cbranch_vccnz L1_skip0_7_1
    v_mfma_f32_32x32x16_bf16 v[48:63], v[140:143], v[164:167], v[48:63]
L1_skip0_7_1:
    ds_read_b128 v[120:123], v7 offset:18432
    s_add_u32 m0, s41, 1024
    s_add_u32 s47, s40, 294912
    buffer_load_dwordx4 v9, s[20:23], s47 offen lds
    s_cbranch_vccnz L1_skip0_7_2
    v_mfma_f32_32x32x16_bf16 v[64:79], v[144:147], v[164:167], v[64:79]
L1_skip0_7_2:
    s_cbranch_vccnz L1_skip0_7_3
    v_mfma_f32_32x32x16_bf16 v[80:95], v[148:151], v[164:167], v[80:95]
L1_skip0_7_3:
    s_waitcnt lgkmcnt(0)
    v_mfma_f32_32x32x16_bf16 v[32:47], v[96:99], v[152:155], v[32:47]
    s_waitcnt vmcnt(10)
    ds_read_b64_tr_b16 v[164:165], v8 offset:3072
    ds_read_b64_tr_b16 v[166:167], v8 offset:3328
    v_mfma_f32_32x32x16_bf16 v[48:63], v[100:103], v[152:155], v[48:63]
    v_xor_b32 v6, 32, v6
    v_xor_b32 v7, 32, v7
    ds_read_b128 v[124:127], v6 offset:0
    ds_read_b128 v[128:131], v6 offset:9216
    s_add_u32 m0, s41, 2048
    s_add_u32 s47, s40, 557056
    buffer_load_dwordx4 v9, s[20:23], s47 offen lds
    v_mfma_f32_32x32x16_bf16 v[64:79], v[104:107], v[152:155], v[64:79]
    v_mfma_f32_32x32x16_bf16 v[80:95], v[108:111], v[152:155], v[80:95]
    s_waitcnt lgkmcnt(0)
    v_mfma_f32_32x32x16_bf16 v[32:47], v[100:103], v[156:159], v[32:47]
    s_waitcnt vmcnt(9)
    ds_read_b64_tr_b16 v[152:153], v8 offset:4096
    ds_read_b64_tr_b16 v[154:155], v8 offset:4352
    v_mfma_f32_32x32x16_bf16 v[48:63], v[104:107], v[156:159], v[48:63]
    ds_read_b128 v[132:135], v6 offset:18432
    ds_read_b128 v[136:139], v6 offset:27648
    s_add_u32 m0, s41, 3072
    s_add_u32 s47, s40, 819200
    buffer_load_dwordx4 v9, s[20:23], s47 offen lds
    v_mfma_f32_32x32x16_bf16 v[64:79], v[108:111], v[156:159], v[64:79]
    v_mfma_f32_32x32x16_bf16 v[80:95], v[112:115], v[156:159], v[80:95]
    s_waitcnt lgkmcnt(0)
    v_mfma_f32_32x32x16_bf16 v[32:47], v[104:107], v[160:163], v[32:47]
    s_waitcnt vmcnt(8)
    ds_read_b64_tr_b16 v[156:157], v8 offset:5120
    ds_read_b64_tr_b16 v[158:159], v8 offset:5376
    v_mfma_f32_32x32x16_bf16 v[48:63], v[108:111], v[160:163], v[48:63]
    ds_read_b128 v[140:143], v7 offset:0
    ds_read_b128 v[144:147], v7 offset:9216
    s_add_u32 m0, s41, 4096
    s_add_u32 s47, s40, 40960
    buffer_load_dwordx4 v9, s[20:23], s47 offen lds
    v_mfma_f32_32x32x16_bf16 v[64:79], v[112:115], v[160:163], v[64:79]
    v_mfma_f32_32x32x16_bf16 v[80:95], v[116:119], v[160:163], v[80:95]
    s_waitcnt lgkmcnt(0)
    s_cbranch_vccnz L1_skip0_11_0
    v_mfma_f32_32x32x16_bf16 v[32:47], v[108:111], v[164:167], v[32:47]
L1_skip0_11_0:
    s_waitcnt vmcnt(7)
    ds_read_b64_tr_b16 v[160:161], v8 offset:6144
    ds_read_b64_tr_b16 v[162:163], v8 offset:6400
    s_cbranch_vccnz L1_skip0_11_1
    v_mfma_f32_32x32x16_bf16 v[48:63], v[112:115], v[164:167], v[48:63]
L1_skip0_11_1:
    ds_read_b128 v[148:151], v7 offset:18432
    s_add_u32 m0, s41, 5120
    s_add_u32 s47, s40, 303104
    buffer_load_dwordx4 v9, s[20:23], s47 offen lds
    s_cbranch_vccnz L1_skip0_11_2
    v_mfma_f32_32x32x16_bf16 v[64:79], v[116:119], v[164:167], v[64:79]
L1_skip0_11_2:
    s_cbranch_vccnz L1_skip0_11_3
    v_mfma_f32_32x32x16_bf16 v[80:95], v[120:123], v[164:167], v[80:95]
L1_skip0_11_3:
    s_waitcnt lgkmcnt(0)
    v_mfma_f32_32x32x16_bf16 v[32:47], v[124:127], v[152:155], v[32:47]
    s_waitcnt vmcnt(6)
    ds_read_b64_tr_b16 v[164:165], v8 offset:7168
    ds_read_b64_tr_b16 v[166:167], v8 offset:7424
    v_mfma_f32_32x32x16_bf16 v[48:63], v[128:131], v[152:155], v[48:63]
    s_add_u32 m0, s41, 6144
    s_add_u32 s47, s40, 565248
    buffer_load_dwordx4 v9, s[20:23], s47 offen lds
    v_mfma_f32_32x32x16_bf16 v[64:79], v[132:135], v[152:155], v[64:79]
    v_mfma_f32_32x32x16_bf16 v[80:95], v[136:139], v[152:155], v[80:95]
    s_waitcnt lgkmcnt(0)
    v_mfma_f32_32x32x16_bf16 v[32:47], v[128:131], v[156:159], v[32:47]
    s_waitcnt vmcnt(8)
    s_barrier
    s_xor_b32 s42, s42, 36864
    s_xor_b32 s43, s42, 36864
    s_add_u32 s43, s43, s50
    s_add_u32 s51, s43, 32768
    s_cmp_ge_u32 s36, 4
    s_cselect_b32 s51, s52, s51
    s_waitcnt vmcnt(6)
    ds_read_b64_tr_b16 v[152:153], v8 offset:0
    ds_read_b64_tr_b16 v[154:155], v8 offset:256
    v_mfma_f32_32x32x16_bf16 v[48:63], v[132:135], v[156:159], v[48:63]
    v_add_u32 v6, s42, v4
    v_add_u32 v7, s42, v5
    ds_read_b128 v[96:99], v6 offset:0
    ds_read_b128 v[100:103], v6 offset:9216
    ds_read_b128 v[104:107], v6 offset:18432
    s_add_u32 m0, s41, 7168
    s_add_u32 s47, s40, 827392
    buffer_load_dwordx4 v9, s[20:23], s47 offen lds
    v_mfma_f32_32x32x16_bf16 v[64:79], v[136:139], v[156:159], v[64:79]
    v_mfma_f32_32x32x16_bf16 v[80:95], v[140:143], v[156:159], v[80:95]
    s_waitcnt lgkmcnt(0)
    v_mfma_f32_32x32x16_bf16 v[32:47], v[132:135], v[160:163], v[32:47]
    s_waitcnt vmcnt(6)
    ds_read_b64_tr_b16 v[156:157], v8 offset:1024
    ds_read_b64_tr_b16 v[158:159], v8 offset:1280
    v_mfma_f32_32x32x16_bf16 v[48:63], v[136:139], v[160:163], v[48:63]
    ds_read_b128 v[108:111], v6 offset:27648
    ds_read_b128 v[112:115], v7 offset:0
    ds_read_b128 v[116:119], v7 offset:9216
    s_add_u32 m0, s41, 0
    s_add_u32 s47, s40, 49152
    buffer_load_dwordx4 v9, s[20:23], s47 offen lds
    v_mfma_f32_32x32x16_bf16 v[64:79], v[140:143], v[160:163], v[64:79]
    v_mfma_f32_32x32x16_bf16 v[80:95], v[144:147], v[160:163], v[80:95]
    s_waitcnt lgkmcnt(0)
    s_cbranch_vccnz L1_skip0_15_0
    v_mfma_f32_32x32x16_bf16 v[32:47], v[136:139], v[164:167], v[32:47]
L1_skip0_15_0:
    s_waitcnt vmcnt(6)
    ds_read_b64_tr_b16 v[160:161], v8 offset:2048
    ds_read_b64_tr_b16 v[162:163], v8 offset:2304
    s_cbranch_vccnz L1_skip0_15_1
    v_mfma_f32_32x32x16_bf16 v[48:63], v[140:143], v[164:167], v[48:63]
L1_skip0_15_1:
    ds_read_b128 v[120:123], v7 offset:18432
    s_add_u32 m0, s41, 1024
    s_add_u32 s47, s40, 311296
    buffer_load_dwordx4 v9, s[20:23], s47 offen lds
    s_cbranch_vccnz L1_skip0_15_2
    v_mfma_f32_32x32x16_bf16 v[64:79], v[144:147], v[164:167], v[64:79]
L1_skip0_15_2:
    s_cbranch_vccnz L1_skip0_15_3
    v_mfma_f32_32x32x16_bf16 v[80:95], v[148:151], v[164:167], v[80:95]
L1_skip0_15_3:
    s_add_u32 s40, s40, 32768
    s_add_u32 s44, s44, 128
    s_add_u32 s46, s46, 1
    s_cmp_lt_u32 s46, 3
    s_cbranch_scc1 L1_loop
    s_waitcnt lgkmcnt(0)
    v_mfma_f32_32x32x16_bf16 v[32:47], v[96:99], v[152:155], v[32:47]
    s_waitcnt vmcnt(6)
    ds_read_b64_tr_b16 v[164:165], v8 offset:3072
    ds_read_b64_tr_b16 v[166:167], v8 offset:3328
    v_mfma_f32_32x32x16_bf16 v[48:63], v[100:103], v[152:155], v[48:63]
    v_xor_b32 v6, 32, v6
    v_xor_b32 v7, 32, v7
    ds_read_b128 v[124:127], v6 offset:0
    ds_read_b128 v[128:131], v6 offset:9216
    s_add_u32 m0, s41, 2048
    s_add_u32 s47, s40, 540672
    buffer_load_dwordx4 v9, s[20:23], s47 offen lds
    v_mfma_f32_32x32x16_bf16 v[64:79], v[104:107], v[152:155], v[64:79]
    v_mfma_f32_32x32x16_bf16 v[80:95], v[108:111], v[152:155], v[80:95]
    s_waitcnt lgkmcnt(0)
    v_mfma_f32_32x32x16_bf16 v[32:47], v[100:103], v[156:159], v[32:47]
    s_waitcnt vmcnt(6)
    ds_read_b64_tr_b16 v[152:153], v8 offset:4096
    ds_read_b64_tr_b16 v[154:155], v8 offset:4352
    v_mfma_f32_32x32x16_bf16 v[48:63], v[104:107], v[156:159], v[48:63]
    ds_read_b128 v[132:135], v6 offset:18432
    ds_read_b128 v[136:139], v6 offset:27648
    s_add_u32 m0, s41, 3072
    s_add_u32 s47, s40, 802816
    buffer_load_dwordx4 v9, s[20:23], s47 offen lds
    v_mfma_f32_32x32x16_bf16 v[64:79], v[108:111], v[156:159], v[64:79]
    v_mfma_f32_32x32x16_bf16 v[80:95], v[112:115], v[156:159], v[80:95]
    s_waitcnt lgkmcnt(0)
    v_mfma_f32_32x32x16_bf16 v[32:47], v[104:107], v[160:163], v[32:47]
    s_waitcnt vmcnt(6)
    ds_read_b64_tr_b16 v[156:157], v8 offset:5120
    ds_read_b64_tr_b16 v[158:159], v8 offset:5376
    v_mfma_f32_32x32x16_bf16 v[48:63], v[108:111], v[160:163], v[48:63]
    ds_read_b128 v[140:143], v7 offset:0
    ds_read_b128 v[144:147], v7 offset:9216
    s_add_u32 m0, s41, 4096
    s_add_u32 s47, s40, 24576
    buffer_load_dwordx4 v9, s[20:23], s47 offen lds
    v_mfma_f32_32x32x16_bf16 v[64:79], v[112:115], v[160:163], v[64:79]
    v_mfma_f32_32x32x16_bf16 v[80:95], v[116:119], v[160:163], v[80:95]
    s_waitcnt lgkmcnt(0)
    s_cbranch_vccnz L1_skip1_3_0
    v_mfma_f32_32x32x16_bf16 v[32:47], v[108:111], v[164:167], v[32:47]
L1_skip1_3_0:
    s_waitcnt vmcnt(6)
    ds_read_b64_tr_b16 v[160:161], v8 offset:6144
    ds_read_b64_tr_b16 v[162:163], v8 offset:6400
    s_cbranch_vccnz L1_skip1_3_1
    v_mfma_f32_32x32x16_bf16 v[48:63], v[112:115], v[164:167], v[48:63]
L1_skip1_3_1:
    ds_read_b128 v[148:151], v7 offset:18432
    s_add_u32 m0, s41, 5120
    s_add_u32 s47, s40, 286720
    buffer_load_dwordx4 v9, s[20:23], s47 offen lds
    s_cbranch_vccnz L1_skip1_3_2
    v_mfma_f32_32x32x16_bf16 v[64:79], v[116:119], v[164:167], v[64:79]
L1_skip1_3_2:
    s_cbranch_vccnz L1_skip1_3_3
    v_mfma_f32_32x32x16_bf16 v[80:95], v[120:123], v[164:167], v[80:95]
L1_skip1_3_3:
    s_waitcnt lgkmcnt(0)
    v_mfma_f32_32x32x16_bf16 v[32:47], v[124:127], v[152:155], v[32:47]
    s_waitcnt vmcnt(6)
    ds_read_b64_tr_b16 v[164:165], v8 offset:7168
    ds_read_b64_tr_b16 v[166:167], v8 offset:7424
    v_mfma_f32_32x32x16_bf16 v[48:63], v[128:131], v[152:155], v[48:63]
    v_xor_b32 v6, 96, v6
    v_xor_b32 v7, 96, v7
    ds_read_b128 v[96:99], v6 offset:0
    ds_read_b128 v[100:103], v6 offset:9216
    s_add_u32 m0, s41, 6144
    s_add_u32 s47, s40, 548864
    buffer_load_dwordx4 v9, s[20:23], s47 offen lds
    v_mfma_f32_32x32x16_bf16 v[64:79], v[132:135], v[152:155], v[64:79]
    v_mfma_f32_32x32x16_bf16 v[80:95], v[136:139], v[152:155], v[80:95]
    s_waitcnt lgkmcnt(0)
    v_mfma_f32_32x32x16_bf16 v[32:47], v[128:131], v[156:159], v[32:47]
    s_waitcnt vmcnt(6)
    ds_read_b64_tr_b16 v[152:153], v8 offset:0
    ds_read_b64_tr_b16 v[154:155], v8 offset:256
    v_mfma_f32_32x32x16_bf16 v[48:63], v[132:135], v[156:159], v[48:63]
    ds_read_b128 v[104:107], v6 offset:18432
    ds_read_b128 v[108:111], v6 offset:27648
    s_add_u32 m0, s41, 7168
    s_add_u32 s47, s40, 811008
    buffer_load_dwordx4 v9, s[20:23], s47 offen lds
    v_mfma_f32_32x32x16_bf16 v[64:79], v[136:139], v[156:159], v[64:79]
    v_mfma_f32_32x32x16_bf16 v[80:95], v[140:143], v[156:159], v[80:95]
    s_waitcnt lgkmcnt(0)
    v_mfma_f32_32x32x16_bf16 v[32:47], v[132:135], v[160:163], v[32:47]
    s_waitcnt vmcnt(6)
    ds_read_b64_tr_b16 v[156:157], v8 offset:1024
    ds_read_b64_tr_b16 v[158:159], v8 offset:1280
    v_mfma_f32_32x32x16_bf16 v[48:63], v[136:139], v[160:163], v[48:63]
    ds_read_b128 v[112:115], v7 offset:0
    ds_read_b128 v[116:119], v7 offset:9216
    v_mfma_f32_32x32x16_bf16 v[64:79], v[140:143], v[160:163], v[64:79]
    v_mfma_f32_32x32x16_bf16 v[80:95], v[144:147], v[160:163], v[80:95]
    s_waitcnt lgkmcnt(0)
    s_cbranch_vccnz L1_skip1_7_0
    v_mfma_f32_32x32x16_bf16 v[32:47], v[136:139], v[164:167], v[32:47]
L1_skip1_7_0:
    s_waitcnt vmcnt(5)
    ds_read_b64_tr_b16 v[160:161], v8 offset:2048
    ds_read_b64_tr_b16 v[162:163], v8 offset:2304
    s_cbranch_vccnz L1_skip1_7_1
    v_mfma_f32_32x32x16_bf16 v[48:63], v[140:143], v[164:167], v[48:63]
L1_skip1_7_1:
    ds_read_b128 v[120:123], v7 offset:18432
    s_cbranch_vccnz L1_skip1_7_2
    v_mfma_f32_32x32x16_bf16 v[64:79], v[144:147], v[164:167], v[64:79]
L1_skip1_7_2:
    s_cbranch_vccnz L1_skip1_7_3
    v_mfma_f32_32x32x16_bf16 v[80:95], v[148:151], v[164:167], v[80:95]
L1_skip1_7_3:
    s_waitcnt lgkmcnt(0)
    v_mfma_f32_32x32x16_bf16 v[32:47], v[96:99], v[152:155], v[32:47]
    s_waitcnt vmcnt(4)
    ds_read_b64_tr_b16 v[164:165], v8 offset:3072
    ds_read_b64_tr_b16 v[166:167], v8 offset:3328
    v_mfma_f32_32x32x16_bf16 v[48:63], v[100:103], v[152:155], v[48:63]
    v_xor_b32 v6, 32, v6
    v_xor_b32 v7, 32, v7
    ds_read_b128 v[124:127], v6 offset:0
    ds_read_b128 v[128:131], v6 offset:9216
    v_mfma_f32_32x32x16_bf16 v[64:79], v[104:107], v[152:155], v[64:79]
    v_mfma_f32_32x32x16_bf16 v[80:95], v[108:111], v[152:155], v[80:95]
    s_waitcnt lgkmcnt(0)
    v_mfma_f32_32x32x16_bf16 v[32:47], v[100:103], v[156:159], v[32:47]
    s_waitcnt vmcnt(3)
    ds_read_b64_tr_b16 v[152:153], v8 offset:4096
    ds_read_b64_tr_b16 v[154:155], v8 offset:4352
    v_mfma_f32_32x32x16_bf16 v[48:63], v[104:107], v[156:159], v[48:63]
    ds_read_b128 v[132:135], v6 offset:18432
    ds_read_b128 v[136:139], v6 offset:27648
    v_mfma_f32_32x32x16_bf16 v[64:79], v[108:111], v[156:159], v[64:79]
    v_mfma_f32_32x32x16_bf16 v[80:95], v[112:115], v[156:159], v[80:95]
    s_waitcnt lgkmcnt(0)
    v_mfma_f32_32x32x16_bf16 v[32:47], v[104:107], v[160:163], v[32:47]
    s_waitcnt vmcnt(2)
    ds_read_b64_tr_b16 v[156:157], v8 offset:5120
    ds_read_b64_tr_b16 v[158:159], v8 offset:5376
    v_mfma_f32_32x32x16_bf16 v[48:63], v[108:111], v[160:163], v[48:63]
    ds_read_b128 v[140:143], v7 offset:0
    ds_read_b128 v[144:147], v7 offset:9216
    v_mfma_f32_32x32x16_bf16 v[64:79], v[112:115], v[160:163], v[64:79]
    v_mfma_f32_32x32x16_bf16 v[80:95], v[116:119], v[160:163], v[80:95]
    s_waitcnt lgkmcnt(0)
    s_cbranch_vccnz L1_skip1_11_0
    v_mfma_f32_32x32x16_bf16 v[32:47], v[108:111], v[164:167], v[32:47]
L1_skip1_11_0:
    s_waitcnt vmcnt(1)
    ds_read_b64_tr_b16 v[160:161], v8 offset:6144
    ds_read_b64_tr_b16 v[162:163], v8 offset:6400
    s_cbranch_vccnz L1_skip1_11_1
    v_mfma_f32_32x32x16_bf16 v[48:63], v[112:115], v[164:167], v[48:63]
L1_skip1_11_1:
    ds_read_b128 v[148:151], v7 offset:18432
    s_cbranch_vccnz L1_skip1_11_2
    v_mfma_f32_32x32x16_bf16 v[64:79], v[116:119], v[164:167], v[64:79]
L1_skip1_11_2:
    s_cbranch_vccnz L1_skip1_11_3
    v_mfma_f32_32x32x16_bf16 v[80:95], v[120:123], v[164:167], v[80:95]
L1_skip1_11_3:
    s_waitcnt lgkmcnt(0)
    v_mfma_f32_32x32x16_bf16 v[32:47], v[124:127], v[152:155], v[32:47]
    s_waitcnt vmcnt(0)
    ds_read_b64_tr_b16 v[164:165], v8 offset:7168
    ds_read_b64_tr_b16 v[166:167], v8 offset:7424
    v_mfma_f32_32x32x16_bf16 v[48:63], v[128:131], v[152:155], v[48:63]
    v_mfma_f32_32x32x16_bf16 v[64:79], v[132:135], v[152:155], v[64:79]
    v_mfma_f32_32x32x16_bf16 v[80:95], v[136:139], v[152:155], v[80:95]
    s_waitcnt lgkmcnt(0)
    v_mfma_f32_32x32x16_bf16 v[32:47], v[128:131], v[156:159], v[32:47]
    v_mfma_f32_32x32x16_bf16 v[48:63], v[132:135], v[156:159], v[48:63]
    v_mfma_f32_32x32x16_bf16 v[64:79], v[136:139], v[156:159], v[64:79]
    v_mfma_f32_32x32x16_bf16 v[80:95], v[140:143], v[156:159], v[80:95]
    s_waitcnt lgkmcnt(0)
    v_mfma_f32_32x32x16_bf16 v[32:47], v[132:135], v[160:163], v[32:47]
    v_mfma_f32_32x32x16_bf16 v[48:63], v[136:139], v[160:163], v[48:63]
    v_mfma_f32_32x32x16_bf16 v[64:79], v[140:143], v[160:163], v[64:79]
    v_mfma_f32_32x32x16_bf16 v[80:95], v[144:147], v[160:163], v[80:95]
    s_waitcnt lgkmcnt(0)
    s_cbranch_vccnz L1_skip1_15_0
    v_mfma_f32_32x32x16_bf16 v[32:47], v[136:139], v[164:167], v[32:47]
L1_skip1_15_0:
    s_cbranch_vccnz L1_skip1_15_1
    v_mfma_f32_32x32x16_bf16 v[48:63], v[140:143], v[164:167], v[48:63]
L1_skip1_15_1:
    s_cbranch_vccnz L1_skip1_15_2
    v_mfma_f32_32x32x16_bf16 v[64:79], v[144:147], v[164:167], v[64:79]
L1_skip1_15_2:
    s_cbranch_vccnz L1_skip1_15_3
    v_mfma_f32_32x32x16_bf16 v[80:95], v[148:151], v[164:167], v[80:95]
L1_skip1_15_3:
    s_add_u32 s40, s40, 32768
    s_add_u32 s44, s44, 128
    s_waitcnt vmcnt(0) lgkmcnt(0)
    s_nop 15
    s_nop 7
    s_barrier
    s_lshl_b32 s58, s36, 14
    v_lshlrev_b32 v16, 4, v1
    v_add_u32 v17, s58, v16
    ds_write_b128 v17, v[32:35] offset:0
    ds_write_b128 v17, v[36:39] offset:1024
    ds_write_b128 v17, v[40:43] offset:2048
    ds_write_b128 v17, v[44:47] offset:3072
    ds_write_b128 v17, v[48:51] offset:4096
    ds_write_b128 v17, v[52:55] offset:5120
    ds_write_b128 v17, v[56:59] offset:6144
    ds_write_b128 v17, v[60:63] offset:7168
    ds_write_b128 v17, v[64:67] offset:8192
    ds_write_b128 v17, v[68:71] offset:9216
    ds_write_b128 v17, v[72:75] offset:10240
    ds_write_b128 v17, v[76:79] offset:11264
    ds_write_b128 v17, v[80:83] offset:12288
    ds_write_b128 v17, v[84:87] offset:13312
    ds_write_b128 v17, v[88:91] offset:14336
    ds_write_b128 v17, v[92:95] offset:15360
    s_waitcnt lgkmcnt(0)
    s_barrier
    s_lshl_b32 s58, s36, 11
    v_add_u32 v17, s58, v16
    v_add_u32 v18, 0x10000, v17
    ds_read_b128 v[96:99], v17 offset:0
    ds_read_b128 v[100:103], v17 offset:1024
    ds_read_b128 v[104:107], v17 offset:16384
    ds_read_b128 v[108:111], v17 offset:17408
    ds_read_b128 v[112:115], v17 offset:32768
    ds_read_b128 v[116:119], v17 offset:33792
    ds_read_b128 v[120:123], v17 offset:49152
    ds_read_b128 v[124:127], v17 offset:50176
    ds_read_b128 v[128:131], v18 offset:0
    ds_read_b128 v[132:135], v18 offset:1024
    ds_read_b128 v[136:139], v18 offset:16384
    ds_read_b128 v[140:143], v18 offset:17408
    ds_read_b128 v[144:147], v18 offset:32768
    ds_read_b128 v[148:151], v18 offset:33792
    ds_read_b128 v[152:155], v18 offset:49152
    ds_read_b128 v[156:159], v18 offset:50176
    s_waitcnt lgkmcnt(0)
    v_add_f32 v32, v96, v104
    v_add_f32 v33, v97, v105
    v_add_f32 v34, v98, v106
    v_add_f32 v35, v99, v107
    v_add_f32 v36, v100, v108
    v_add_f32 v37, v101, v109
    v_add_f32 v38, v102, v110
    v_add_f32 v39, v103, v111
    v_add_f32 v32, v32, v112
    v_add_f32 v33, v33, v113
    v_add_f32 v34, v34, v114
    v_add_f32 v35, v35, v115
    v_add_f32 v36, v36, v116
    v_add_f32 v37, v37, v117
    v_add_f32 v38, v38, v118
    v_add_f32 v39, v39, v119
    v_add_f32 v32, v32, v120
    v_add_f32 v33, v33, v121
    v_add_f32 v34, v34, v122
    v_add_f32 v35, v35, v123
    v_add_f32 v36, v36, v124
    v_add_f32 v37, v37, v125
    v_add_f32 v38, v38, v126
    v_add_f32 v39, v39, v127
    v_add_f32 v32, v32, v128
    v_add_f32 v33, v33, v129
    v_add_f32 v34, v34, v130
    v_add_f32 v35, v35, v131
    v_add_f32 v36, v36, v132
    v_add_f32 v37, v37, v133
    v_add_f32 v38, v38, v134
    v_add_f32 v39, v39, v135
    v_add_f32 v32, v32, v136
    v_add_f32 v33, v33, v137
    v_add_f32 v34, v34, v138
    v_add_f32 v35, v35, v139
    v_add_f32 v36, v36, v140
    v_add_f32 v37, v37, v141
    v_add_f32 v38, v38, v142
    v_add_f32 v39, v39, v143
    v_add_f32 v32, v32, v144
    v_add_f32 v33, v33, v145
    v_add_f32 v34, v34, v146
    v_add_f32 v35, v35, v147
    v_add_f32 v36, v36, v148
    v_add_f32 v37, v37, v149
    v_add_f32 v38, v38, v150
    v_add_f32 v39, v39, v151
    v_add_f32 v32, v32, v152
    v_add_f32 v33, v33, v153
    v_add_f32 v34, v34, v154
    v_add_f32 v35, v35, v155
    v_add_f32 v36, v36, v156
    v_add_f32 v37, v37, v157
    v_add_f32 v38, v38, v158
    v_add_f32 v39, v39, v159
    v_lshlrev_b32 v15, 16, v15
    v_cvt_pk_bf16_f32 v40, v32, v33
    v_cvt_pk_bf16_f32 v41, v34, v35
    v_cvt_pk_bf16_f32 v42, v36, v37
    v_cvt_pk_bf16_f32 v43, v38, v39
    v_lshlrev_b32 v32, 16, v40
    v_and_b32 v33, 0xffff0000, v40
    v_lshlrev_b32 v34, 16, v41
    v_and_b32 v35, 0xffff0000, v41
    v_lshlrev_b32 v36, 16, v42
    v_and_b32 v37, 0xffff0000, v42
    v_lshlrev_b32 v38, 16, v43
    v_and_b32 v39, 0xffff0000, v43
    v_add_f32 v32, v32, v15
    v_add_f32 v33, v33, v15
    v_add_f32 v34, v34, v15
    v_add_f32 v35, v35, v15
    v_add_f32 v36, v36, v15
    v_add_f32 v37, v37, v15
    v_add_f32 v38, v38, v15
    v_add_f32 v39, v39, v15
    v_cvt_pk_bf16_f32 v40, v32, v33
    v_cvt_pk_bf16_f32 v41, v34, v35
    v_cvt_pk_bf16_f32 v42, v36, v37
    v_cvt_pk_bf16_f32 v43, v38, v39
    v_lshlrev_b32 v32, 16, v40
    v_and_b32 v33, 0xffff0000, v40
    v_lshlrev_b32 v34, 16, v41
    v_and_b32 v35, 0xffff0000, v41
    v_lshlrev_b32 v36, 16, v42
    v_and_b32 v37, 0xffff0000, v42
    v_lshlrev_b32 v38, 16, v43
    v_and_b32 v39, 0xffff0000, v43
    s_lshl_b32 s58, s36, 10
    s_add_u32 s58, s58, 131072
    v_lshlrev_b32 v16, 8, v3
    v_lshlrev_b32 v17, 1, v2
    v_add_u32 v16, v16, v17
    v_add_u32 v16, s58, v16
    ds_write_b16 v16, v40 offset:0
    ds_write_b16_d16_hi v16, v40 offset:64
    ds_write_b16 v16, v41 offset:128
    ds_write_b16_d16_hi v16, v41 offset:192
    ds_write_b16 v16, v42 offset:512
    ds_write_b16_d16_hi v16, v42 offset:576
    ds_write_b16 v16, v43 offset:640
    ds_write_b16_d16_hi v16, v43 offset:704
    v_lshlrev_b32 v17, 4, v1
    v_add_u32 v17, s58, v17
    s_waitcnt lgkmcnt(0)
    ds_read_b128 v[44:47], v17
    s_and_b32 s58, s36, 1
    s_lshl_b32 s58, s58, 6
    s_lshr_b32 s59, s36, 1
    s_add_u32 s58, s58, s59
    s_add_u32 s58, s58, s48
    v_lshrrev_b32 v18, 2, v1
    v_lshrrev_b32 v19, 2, v18
    v_lshlrev_b32 v19, 4, v19
    v_and_b32 v18, 3, v18
    v_lshlrev_b32 v18, 2, v18
    v_add_u32 v18, v18, v19
    v_add_u32 v18, s58, v18
    s_mul_i32 s59, s37, 1985
    v_add_u32 v19, s59, v18
    v_lshlrev_b32 v19, 9, v19
    v_and_b32 v20, 3, v1
    v_lshlrev_b32 v20, 4, v20
    v_add_u32 v19, v19, v20
    s_lshl_b32 s59, s49, 1
    v_add_u32 v19, s59, v19
    v_cmp_gt_u32 vcc, 1985, v18
    s_and_saveexec_b64 s[60:61], vcc
    s_cbranch_execz L1_nostore
    s_waitcnt lgkmcnt(0)
    buffer_store_dwordx4 v[44:47], v19, s[24:27], 0 offen
L1_nostore:
    s_mov_b64 exec, s[60:61]
    s_sub_u32 s58, 1985, s58
    v_lshlrev_b32 v16, 4, v3
    v_sub_u32 v16, s58, v16
    v_cmp_lt_i32 vcc, 0, v16
    s_nop 1
    v_cndmask_b32 v48, 0, v32, vcc
    v_cmp_lt_i32 vcc, 4, v16
    s_nop 1
    v_cndmask_b32 v49, 0, v33, vcc
    v_cmp_lt_i32 vcc, 8, v16
    s_nop 1
    v_cndmask_b32 v50, 0, v34, vcc
    v_cmp_lt_i32 vcc, 12, v16
    s_nop 1
    v_cndmask_b32 v51, 0, v35, vcc
    v_cmp_lt_i32 vcc, 32, v16
    s_nop 1
    v_cndmask_b32 v52, 0, v36, vcc
    v_cmp_lt_i32 vcc, 36, v16
    s_nop 1
    v_cndmask_b32 v53, 0, v37, vcc
    v_cmp_lt_i32 vcc, 40, v16
    s_nop 1
    v_cndmask_b32 v54, 0, v38, vcc
    v_cmp_lt_i32 vcc, 44, v16
    s_nop 1
    v_cndmask_b32 v55, 0, v39, vcc
    v_add_f32 v17, v48, v49
    v_add_f32 v17, v17, v50
    v_add_f32 v17, v17, v51
    v_add_f32 v17, v17, v52
    v_add_f32 v17, v17, v53
    v_add_f32 v17, v17, v54
    v_add_f32 v17, v17, v55
    v_mul_f32 v24, v48, v48
    v_fma_f32 v24, v49, v49, v24
    v_fma_f32 v24, v50, v50, v24
    v_fma_f32 v24, v51, v51, v24
    v_fma_f32 v24, v52, v52, v24
    v_fma_f32 v24, v53, v53, v24
    v_fma_f32 v24, v54, v54, v24
    v_fma_f32 v24, v55, v55, v24
    v_mov_b32 v18, v17
    s_nop 1
    v_permlane32_swap_b32 v17, v18
    s_nop 1
    v_add_f32 v17, v17, v18
    v_mov_b32 v18, v24
    s_nop 1
    v_permlane32_swap_b32 v24, v18
    s_nop 1
    v_add_f32 v24, v24, v18
    v_lshlrev_b32 v19, 5, v2
    s_lshl_b32 s58, s36, 2
    s_add_u32 s58, s58, 139264
    v_add_u32 v19, s58, v19
    ds_write_b32 v19, v17
    ds_write_b32 v19, v24 offset:1024
    s_waitcnt lgkmcnt(0)
    s_barrier
    s_cmp_lg_u32 s36, 0
    s_cbranch_scc1 L1_end
    v_lshlrev_b32 v20, 5, v2
    v_add_u32 v20, 139264, v20
    ds_read_b128 v[56:59], v20
    ds_read_b128 v[60:63], v20 offset:16
    ds_read_b128 v[64:67], v20 offset:1024
    ds_read_b128 v[68:71], v20 offset:1040
    s_sub_u32 s58, 1985, s48
    s_min_u32 s58, s58, 128
    s_mov_b32 s62, s58
    v_cvt_f32_u32 v22, s58
    v_rcp_f32 v22, v22
    s_waitcnt lgkmcnt(0)
    v_add_f32 v21, v56, v57
    v_add_f32 v21, v21, v58
    v_add_f32 v21, v21, v59
    v_add_f32 v21, v21, v60
    v_add_f32 v21, v21, v61
    v_add_f32 v21, v21, v62
    v_add_f32 v21, v21, v63
    v_add_f32 v56, v64, v65
    v_add_f32 v56, v56, v66
    v_add_f32 v56, v56, v67
    v_add_f32 v56, v56, v68
    v_add_f32 v56, v56, v69
    v_add_f32 v56, v56, v70
    v_add_f32 v56, v56, v71
    v_mul_f32 v57, v21, v22
    v_fma_f32 v57, -v21, v57, v56
    v_max_f32 v22, 0, v57
    s_lshl_b32 s58, s37, 4
    s_add_u32 s58, s58, s38
    s_lshl_b32 s58, s58, 8
    s_add_u32 s58, s58, s49
    v_add_u32 v23, s58, v2
    v_lshlrev_b32 v23, 3, v23
    v_cvt_f32_u32 v56, s62
    v_rcp_f32 v56, v56
    s_nop 0
    v_mul_f32 v56, v21, v56
    v_mov_b32 v57, v22
    v_cmp_gt_u32 vcc, 32, v1
    s_and_saveexec_b64 s[60:61], vcc
    buffer_store_dwordx2 v[56:57], v23, s[28:31], 0 offen
L1_end:
    s_endpgm
L1_pf:
    v_lshlrev_b32 v16, 9, v1
    s_and_b32 s58, s39, 1
    s_lshl_b32 s58, s58, 4
    s_add_u32 s58, s58, s38
    s_lshl_b32 s58, s58, 17
    s_lshl_b32 s59, s49, 1
    s_add_u32 s58, s58, s59
    v_add_u32 v16, s58, v16
    s_mov_b32 s58, 0
    buffer_load_dword v32, v16, s[20:23], s58 offen
    s_barrier
    s_mov_b32 s58, 32768
    buffer_load_dword v33, v16, s[20:23], s58 offen
    s_barrier
    s_mov_b32 s58, 65536
    buffer_load_dword v34, v16, s[20:23], s58 offen
    s_barrier
    s_mov_b32 s58, 98304
    buffer_load_dword v35, v16, s[20:23], s58 offen
    s_waitcnt vmcnt(0)
    s_endpgm
.globl norm_kernel
.p2align 8
.type norm_kernel,@function
norm_kernel:
    s_cmp_ge_u32 s2, 256
    s_cbranch_scc1 L2_end
    s_load_dwordx4 s[4:7], s[0:1], 24
    s_load_dwordx2 s[10:11], s[0:1], 40
    s_load_dwordx2 s[12:13], s[0:1], 56
    v_and_b32 v1, 63, v0
    v_lshrrev_b32 v5, 6, v0
    v_and_b32 v2, 31, v0
    v_lshrrev_b32 v3, 5, v1
    v_readfirstlane_b32 s36, v5
    s_and_b32 s44, s2, 7
    s_lshr_b32 s45, s2, 3
    s_lshr_b32 s37, s44, 2
    s_and_b32 s44, s44, 3
    s_lshl_b32 s44, s44, 1
    s_and_b32 s46, s45, 1
    s_or_b32 s39, s44, s46
    s_lshr_b32 s38, s45, 1
    s_lshl_b32 s40, s38, 7
    s_lshl_b32 s41, s39, 5
    s_waitcnt lgkmcnt(0)
    s_mov_b32 s24, s4
    s_mov_b32 s25, s5
    s_mov_b32 s26, 512
    s_mov_b32 s27, 0x00020000
    s_mov_b32 s28, s6
    s_mov_b32 s29, s7
    s_mov_b32 s30, 512
    s_mov_b32 s31, 0x00020000
    s_mov_b32 s16, s10
    s_mov_b32 s17, s11
    s_mov_b32 s18, 2032640
    s_mov_b32 s19, 0x00020000
    s_mov_b32 s20, s12
    s_mov_b32 s21, s13
    s_mov_b32 s22, 65536
    s_mov_b32 s23, 0x00020000
    v_lshrrev_b32 v4, 2, v0
    v_add_u32 v4, s40, v4
    s_mul_i32 s44, s37, 1985
    v_add_u32 v5, s44, v4
    v_lshlrev_b32 v5, 9, v5
    v_and_b32 v6, 3, v0
    v_lshlrev_b32 v7, 4, v6
    v_add_u32 v5, v5, v7
    s_lshl_b32 s44, s41, 1
    v_add_u32 v5, s44, v5
    s_lshl_b32 s44, s37, 4
    v_lshlrev_b32 v8, 3, v3
    v_add_u32 v8, s44, v8
    v_lshlrev_b32 v8, 8, v8
    v_add_u32 v8, s41, v8
    v_add_u32 v8, v8, v2
    v_lshlrev_b32 v8, 3, v8
    s_mov_b32 s48, 0
    buffer_load_dwordx2 v[64:65], v8, s[20:23], s48 offen offset:0
    buffer_load_dwordx2 v[66:67], v8, s[20:23], s48 offen offset:2048
    s_mov_b32 s48, 4096
    buffer_load_dwordx2 v[68:69], v8, s[20:23], s48 offen offset:0
    buffer_load_dwordx2 v[70:71], v8, s[20:23], s48 offen offset:2048
    s_mov_b32 s48, 8192
    buffer_load_dwordx2 v[72:73], v8, s[20:23], s48 offen offset:0
    buffer_load_dwordx2 v[74:75], v8, s[20:23], s48 offen offset:2048
    s_mov_b32 s48, 12288
    buffer_load_dwordx2 v[76:77], v8, s[20:23], s48 offen offset:0
    buffer_load_dwordx2 v[78:79], v8, s[20:23], s48 offen offset:2048
    v_lshlrev_b32 v9, 4, v6
    s_lshl_b32 s45, s41, 1
    v_add_u32 v9, s45, v9
    buffer_load_dwordx4 v[12:15], v9, s[24:27], 0 offen
    buffer_load_dwordx4 v[16:19], v9, s[28:31], 0 offen
    v_cmp_gt_u32 vcc, 1985, v4
    s_and_saveexec_b64 s[46:47], vcc
    s_cbranch_execz L2_noload
    buffer_load_dwordx4 v[20:23], v5, s[16:19], 0 offen
L2_noload:
    s_mov_b64 exec, s[46:47]
    s_waitcnt vmcnt(0)
    v_mov_b32 v10, 0x43000000
    v_cmp_eq_u32 vcc, 1, v3
    s_nop 1
    v_mov_b32 v24, 0x42820000
    v_cndmask_b32 v11, v10, v24, vcc
    v_add_f32 v25, v64, v66
    v_add_f32 v25, v25, v68
    v_add_f32 v25, v25, v70
    v_add_f32 v25, v25, v72
    v_add_f32 v25, v25, v74
    v_add_f32 v25, v25, v76
    v_mul_f32 v25, v25, v10
    v_fma_f32 v25, v78, v11, v25
    v_mov_b32 v26, v25
    s_nop 1
    v_permlane32_swap_b32 v25, v26
    s_nop 1
    v_add_f32 v25, v25, v26
    v_mul_f32 v25, 0x3a040ffe, v25
    v_mov_b32 v27, 0
    v_sub_f32 v26, v64, v25
    v_mul_f32 v26, v26, v26
    v_fma_f32 v26, v26, v10, v65
    v_add_f32 v27, v27, v26
    v_sub_f32 v26, v66, v25
    v_mul_f32 v26, v26, v26
    v_fma_f32 v26, v26, v10, v67
    v_add_f32 v27, v27, v26
    v_sub_f32 v26, v68, v25
    v_mul_f32 v26, v26, v26
    v_fma_f32 v26, v26, v10, v69
    v_add_f32 v27, v27, v26
    v_sub_f32 v26, v70, v25
    v_mul_f32 v26, v26, v26
    v_fma_f32 v26, v26, v10, v71
    v_add_f32 v27, v27, v26
    v_sub_f32 v26, v72, v25
    v_mul_f32 v26, v26, v26
    v_fma_f32 v26, v26, v10, v73
    v_add_f32 v27, v27, v26
    v_sub_f32 v26, v74, v25
    v_mul_f32 v26, v26, v26
    v_fma_f32 v26, v26, v10, v75
    v_add_f32 v27, v27, v26
    v_sub_f32 v26, v76, v25
    v_mul_f32 v26, v26, v26
    v_fma_f32 v26, v26, v10, v77
    v_add_f32 v27, v27, v26
    v_sub_f32 v26, v78, v25
    v_mul_f32 v26, v26, v26
    v_fma_f32 v26, v26, v11, v79
    v_add_f32 v27, v27, v26
    v_mov_b32 v26, v27
    s_nop 1
    v_permlane32_swap_b32 v27, v26
    s_nop 1
    v_add_f32 v27, v27, v26
    v_mul_f32 v27, 0x3a040ffe, v27
    v_cvt_pk_bf16_f32 v26, v25, v25
    v_lshlrev_b32 v26, 16, v26
    v_sub_f32 v28, v25, v26
    v_fma_f32 v27, v28, v28, v27
    v_cvt_pk_bf16_f32 v27, v27, v27
    v_lshlrev_b32 v27, 16, v27
    v_add_f32 v27, 0x3727c5ac, v27
    v_cvt_pk_bf16_f32 v27, v27, v27
    v_lshlrev_b32 v27, 16, v27
    v_sqrt_f32 v27, v27
    s_nop 0
    v_cvt_pk_bf16_f32 v27, v27, v27
    v_lshlrev_b32 v27, 16, v27
    v_rcp_f32 v28, v27
    s_nop 0
    s_lshl_b32 s44, s36, 8
    v_lshlrev_b32 v29, 3, v2
    v_add_u32 v29, s44, v29
    v_mov_b32 v30, v26
    v_mov_b32 v31, v28
    ds_write_b64 v29, v[30:31]
    v_lshlrev_b32 v29, 6, v6
    v_add_u32 v29, s44, v29
    s_waitcnt lgkmcnt(0)
    ds_read_b128 v[32:35], v29 offset:0
    ds_read_b128 v[36:39], v29 offset:16
    ds_read_b128 v[40:43], v29 offset:32
    ds_read_b128 v[44:47], v29 offset:48
    s_waitcnt lgkmcnt(0)
    v_lshlrev_b32 v48, 16, v20
    v_and_b32 v49, 0xffff0000, v20
    v_lshlrev_b32 v50, 16, v21
    v_and_b32 v51, 0xffff0000, v21
    v_lshlrev_b32 v52, 16, v22
    v_and_b32 v53, 0xffff0000, v22
    v_lshlrev_b32 v54, 16, v23
    v_and_b32 v55, 0xffff0000, v23
    v_sub_f32 v48, v48, v32
    v_sub_f32 v49, v49, v34
    v_sub_f32 v50, v50, v36
    v_sub_f32 v51, v51, v38
    v_sub_f32 v52, v52, v40
    v_sub_f32 v53, v53, v42
    v_sub_f32 v54, v54, v44
    v_sub_f32 v55, v55, v46
    v_cvt_pk_bf16_f32 v56, v48, v49
    v_cvt_pk_bf16_f32 v57, v50, v51
    v_cvt_pk_bf16_f32 v58, v52, v53
    v_cvt_pk_bf16_f32 v59, v54, v55
    v_lshlrev_b32 v48, 16, v56
    v_and_b32 v49, 0xffff0000, v56
    v_lshlrev_b32 v50, 16, v57
    v_and_b32 v51, 0xffff0000, v57
    v_lshlrev_b32 v52, 16, v58
    v_and_b32 v53, 0xffff0000, v58
    v_lshlrev_b32 v54, 16, v59
    v_and_b32 v55, 0xffff0000, v59
    v_mul_f32 v48, v48, v33
    v_mul_f32 v49, v49, v35
    v_mul_f32 v50, v50, v37
    v_mul_f32 v51, v51, v39
    v_mul_f32 v52, v52, v41
    v_mul_f32 v53, v53, v43
    v_mul_f32 v54, v54, v45
    v_mul_f32 v55, v55, v47
    v_cvt_pk_bf16_f32 v56, v48, v49
    v_cvt_pk_bf16_f32 v57, v50, v51
    v_cvt_pk_bf16_f32 v58, v52, v53
    v_cvt_pk_bf16_f32 v59, v54, v55
    v_lshlrev_b32 v48, 16, v56
    v_and_b32 v49, 0xffff0000, v56
    v_lshlrev_b32 v50, 16, v57
    v_and_b32 v51, 0xffff0000, v57
    v_lshlrev_b32 v52, 16, v58
    v_and_b32 v53, 0xffff0000, v58
    v_lshlrev_b32 v54, 16, v59
    v_and_b32 v55, 0xffff0000, v59
    v_lshlrev_b32 v60, 16, v12
    v_and_b32 v61, 0xffff0000, v12
    v_mul_f32 v48, v48, v60
    v_mul_f32 v49, v49, v61
    v_lshlrev_b32 v60, 16, v13
    v_and_b32 v61, 0xffff0000, v13
    v_mul_f32 v50, v50, v60
    v_mul_f32 v51, v51, v61
    v_lshlrev_b32 v60, 16, v14
    v_and_b32 v61, 0xffff0000, v14
    v_mul_f32 v52, v52, v60
    v_mul_f32 v53, v53, v61
    v_lshlrev_b32 v60, 16, v15
    v_and_b32 v61, 0xffff0000, v15
    v_mul_f32 v54, v54, v60
    v_mul_f32 v55, v55, v61
    v_cvt_pk_bf16_f32 v56, v48, v49
    v_cvt_pk_bf16_f32 v57, v50, v51
    v_cvt_pk_bf16_f32 v58, v52, v53
    v_cvt_pk_bf16_f32 v59, v54, v55
    v_lshlrev_b32 v48, 16, v56
    v_and_b32 v49, 0xffff0000, v56
    v_lshlrev_b32 v50, 16, v57
    v_and_b32 v51, 0xffff0000, v57
    v_lshlrev_b32 v52, 16, v58
    v_and_b32 v53, 0xffff0000, v58
    v_lshlrev_b32 v54, 16, v59
    v_and_b32 v55, 0xffff0000, v59
    v_lshlrev_b32 v60, 16, v16
    v_and_b32 v61, 0xffff0000, v16
    v_add_f32 v48, v48, v60
    v_add_f32 v49, v49, v61
    v_lshlrev_b32 v60, 16, v17
    v_and_b32 v61, 0xffff0000, v17
    v_add_f32 v50, v50, v60
    v_add_f32 v51, v51, v61
    v_lshlrev_b32 v60, 16, v18
    v_and_b32 v61, 0xffff0000, v18
    v_add_f32 v52, v52, v60
    v_add_f32 v53, v53, v61
    v_lshlrev_b32 v60, 16, v19
    v_and_b32 v61, 0xffff0000, v19
    v_add_f32 v54, v54, v60
    v_add_f32 v55, v55, v61
    v_cvt_pk_bf16_f32 v56, v48, v49
    v_cvt_pk_bf16_f32 v57, v50, v51
    v_cvt_pk_bf16_f32 v58, v52, v53
    v_cvt_pk_bf16_f32 v59, v54, v55
    v_lshlrev_b32 v48, 16, v56
    v_and_b32 v49, 0xffff0000, v56
    v_lshlrev_b32 v50, 16, v57
    v_and_b32 v51, 0xffff0000, v57
    v_lshlrev_b32 v52, 16, v58
    v_and_b32 v53, 0xffff0000, v58
    v_lshlrev_b32 v54, 16, v59
    v_and_b32 v55, 0xffff0000, v59
    v_mov_b32 v62, 0xbdd2d3e8
    v_mov_b32 v63, 0xc0135761
    v_mul_f32 v64, v48, v48
    v_fma_f32 v64, v64, v62, v63
    v_mul_f32 v64, v64, v48
    v_mul_f32 v65, v49, v49
    v_fma_f32 v65, v65, v62, v63
    v_mul_f32 v65, v65, v49
    v_mul_f32 v66, v50, v50
    v_fma_f32 v66, v66, v62, v63
    v_mul_f32 v66, v66, v50
    v_mul_f32 v67, v51, v51
    v_fma_f32 v67, v67, v62, v63
    v_mul_f32 v67, v67, v51
    v_mul_f32 v68, v52, v52
    v_fma_f32 v68, v68, v62, v63
    v_mul_f32 v68, v68, v52
    v_mul_f32 v69, v53, v53
    v_fma_f32 v69, v69, v62, v63
    v_mul_f32 v69, v69, v53
    v_mul_f32 v70, v54, v54
    v_fma_f32 v70, v70, v62, v63
    v_mul_f32 v70, v70, v54
    v_mul_f32 v71, v55, v55
    v_fma_f32 v71, v71, v62, v63
    v_mul_f32 v71, v71, v55
    v_exp_f32 v64, v64
    v_exp_f32 v65, v65
    v_exp_f32 v66, v66
    v_exp_f32 v67, v67
    v_exp_f32 v68, v68
    v_exp_f32 v69, v69
    v_exp_f32 v70, v70
    v_exp_f32 v71, v71
    s_nop 0
    v_add_f32 v64, 1.0, v64
    v_add_f32 v65, 1.0, v65
    v_add_f32 v66, 1.0, v66
    v_add_f32 v67, 1.0, v67
    v_add_f32 v68, 1.0, v68
    v_add_f32 v69, 1.0, v69
    v_add_f32 v70, 1.0, v70
    v_add_f32 v71, 1.0, v71
    v_rcp_f32 v64, v64
    v_rcp_f32 v65, v65
    v_rcp_f32 v66, v66
    v_rcp_f32 v67, v67
    v_rcp_f32 v68, v68
    v_rcp_f32 v69, v69
    v_rcp_f32 v70, v70
    v_rcp_f32 v71, v71
    s_nop 0
    v_mul_f32 v48, v48, v64
    v_mul_f32 v49, v49, v65
    v_mul_f32 v50, v50, v66
    v_mul_f32 v51, v51, v67
    v_mul_f32 v52, v52, v68
    v_mul_f32 v53, v53, v69
    v_mul_f32 v54, v54, v70
    v_mul_f32 v55, v55, v71
    v_cvt_pk_bf16_f32 v56, v48, v49
    v_cvt_pk_bf16_f32 v57, v50, v51
    v_cvt_pk_bf16_f32 v58, v52, v53
    v_cvt_pk_bf16_f32 v59, v54, v55
    v_cmp_gt_u32 vcc, 1985, v4
    s_and_saveexec_b64 s[46:47], vcc
    s_cbranch_execz L2_end
    buffer_store_dwordx4 v[56:59], v5, s[16:19], 0 offen
L2_end:
    s_endpgm
.section .rodata,"a"
.p2align 6
.amdhsa_kernel conv_kernel
  .amdhsa_next_free_vgpr 168
  .amdhsa_next_free_sgpr 102
  .amdhsa_accum_offset 168
  .amdhsa_group_segment_fixed_size 0
  .amdhsa_kernarg_size 64
  .amdhsa_user_sgpr_count 2
  .amdhsa_user_sgpr_kernarg_segment_ptr 1
  .amdhsa_system_sgpr_workgroup_id_x 1
.end_amdhsa_kernel
.p2align 6
.amdhsa_kernel norm_kernel
  .amdhsa_next_free_vgpr 256
  .amdhsa_next_free_sgpr 102
  .amdhsa_accum_offset 256
  .amdhsa_group_segment_fixed_size 0
  .amdhsa_kernarg_size 64
  .amdhsa_user_sgpr_count 2
  .amdhsa_user_sgpr_kernarg_segment_ptr 1
  .amdhsa_system_sgpr_workgroup_id_x 1
.end_amdhsa_kernel
```
